```python
import torch

def _softmax(x, axis=-1):
    return torch.softmax(x, dim=axis)
def _gelu(x):
    return torch.nn.functional.gelu(x, approximate="tanh")
def _silu(x):
    return torch.nn.functional.silu(x)
def _sigmoid(x):
    return torch.sigmoid(x)
def _layernorm(x, axis=-1, eps=1e-5):
    m = x.mean(dim=axis, keepdim=True)
    v = x.var(dim=axis, keepdim=True, unbiased=False)
    return (x - m) / torch.sqrt(v + eps)
def _scatter_add(tgt, idx, src, axis=0):
    return tgt.clone().index_add_(axis, idx, src)
def _segment_sum(src, seg, n):
    out = torch.zeros((n,) + src.shape[1:], dtype=src.dtype)
    return out.index_add_(0, seg, src)
def _pad(x, pw):
    flat = tuple(v for pair in reversed(pw) for v in pair)
    return torch.nn.functional.pad(x, flat)

kernel_name = 'standalone__fused_io_aware_attn__prompt'

def setup_inputs():

    _w = (lambda a: (lambda t: t.to(torch.bfloat16) if t.is_floating_point() else t)(torch.as_tensor(a)))
    B, H, S = 2, 32, 2048
    Dh = max(1, 576 // 32)
    return {
        "q": _w((lambda *s: torch.randn(*s, dtype=torch.bfloat16) * 0.8)(B, H, S, Dh)),
        "k": _w((lambda *s: torch.randn(*s, dtype=torch.bfloat16) * 0.8)(B, H, S, Dh)),
        "v": _w((lambda *s: torch.randn(*s, dtype=torch.bfloat16) * 0.05)(B, H, S, Dh)),
    }

def reference(q, k, v):
    scale = q.shape[-1] ** -0.5
    s = torch.einsum('bhqd,bhkd->bhqk', q, k) * scale
    p = _softmax(s, axis=-1)
    return torch.einsum('bhqk,bhkd->bhqd', p, v)
```

```asm
; @launch grid=(256,1,1) block=(512,1,1) lds=159744
.amdgcn_target "amdgcn-amd-amdhsa--gfx950"
.text
.globl standalone__fused_io_aware_attn__prompt_kernel
.p2align 8
.type standalone__fused_io_aware_attn__prompt_kernel,@function
standalone__fused_io_aware_attn__prompt_kernel:
    s_load_dwordx8 s[4:11], s[0:1], 0
    s_getpc_b64 s[36:37]
    v_mad_u64_u32 v[16:17], vcc, v0, 14, s[36:37]
    global_load_ubyte v15, v[16:17], off offset:116
    v_readfirstlane_b32 s24, v0
    s_and_b32 s3, s2, 7
    s_lshr_b32 s25, s2, 3
    s_lshl_b32 s3, s3, 5
    s_add_u32 s3, s3, s25
    s_cmpk_ge_u32 s2, 256
    s_cbranch_scc1 L_end
    s_cmpk_ge_u32 s24, 256
    s_cbranch_scc1 L_setup
    s_lshr_b32 s25, s3, 2
    s_mul_i32 s25, s25, 73728
    s_mul_i32 s26, s24, 20
    s_add_u32 s26, s26, s25
    v_lshl_add_u32 v60, v0, 4, s26
    s_mul_i32 s26, s24, 36
    s_add_u32 m0, s26, 73728
    s_waitcnt lgkmcnt(0)
    global_load_lds_dwordx4 v60, s[8:9]
    global_load_lds_dwordx4 v60, s[8:9] offset:1024
    s_mov_b64 exec, 0xffff
    global_load_lds_dwordx4 v60, s[8:9] offset:2048
    s_mov_b64 exec, -1
    s_add_u32 s25, s25, s26
    s_add_u32 s42, s6, s25
    s_addc_u32 s43, s7, 0
    s_mov_b32 m0, s26
    v_and_b32 v64, 31, v0
    v_bfe_u32 v65, v0, 5, 1
    v_mul_u32_u24 v184, 72, v64
    v_mad_u32_u24 v185, v65, 36, v184
    v_lshl_add_u32 v184, v65, 4, v184
    global_load_lds_dwordx4 v184, s[42:43]
    s_add_u32 m0, s26, 988
    v_lshl_add_u32 v7, s3, 9, v0
    v_mul_u32_u24 v7, 36, v7
    global_load_lds_dwordx4 v184, s[42:43] offset:36
    s_add_u32 m0, s26, 2016
    v_mul_u32_u24 v186, 1136, v65
    v_sub_u32 v186, v7, v186
    global_load_lds_dword v185, s[42:43] offset:32
    global_load_dword v96, v7, s[4:5] offset:32
    global_load_dwordx4 v[88:91], v186, s[4:5]
    global_load_dwordx4 v[92:95], v186, s[4:5] offset:1152
L_setup:
    v_lshl_add_u32 v7, s3, 9, v0
    v_mul_u32_u24 v7, 36, v7
    v_and_b32 v64, 31, v0
    v_bfe_u32 v65, v0, 5, 1
    v_mul_u32_u24 v184, 72, v64
    v_mad_u32_u24 v185, v65, 36, v184
    v_lshl_add_u32 v184, v65, 4, v184
    v_mul_u32_u24 v186, 1136, v65
    v_sub_u32 v186, v7, v186
    v_lshlrev_b32 v1, 3, v0
    v_and_b32 v0, 63, v0
    s_lshr_b32 s24, s24, 6
    s_lshr_b32 s25, s3, 2
    s_mul_i32 s25, s25, 73728
    s_lshl3_add_u32 s26, s3, s24
    s_mul_i32 s26, s26, 2304
    v_lshlrev_b32 v14, 4, v0
    s_cmp_lt_u32 s24, 4
    s_cselect_b32 s28, 8, 0
    s_add_u32 s28, s28, s24
    s_mul_i32 s27, s28, 2304
    s_mov_b32 s18, 73728
    s_mov_b32 s19, 0x00020000
    s_mov_b32 s46, 73728
    s_mov_b32 s47, 0x00020000
    s_movk_i32 s22, 2304
    s_mov_b32 s23, 0x00020000
    s_waitcnt lgkmcnt(0)
    s_add_u32 s16, s6, s25
    s_addc_u32 s17, s7, 0
    s_add_u32 s44, s8, s25
    s_addc_u32 s45, s9, 0
    s_add_u32 s20, s10, s26
    s_addc_u32 s21, s11, 0
    v_cmp_eq_u32 vcc, 20, v64
    v_mov_b32 v10, 0
    v_mov_b32 v11, 0
    v_mov_b32 v61, 0x3f803f80
    s_mov_b32 s12, 0x0003ffff
    s_mov_b32 s13, 0x0003ffff
    s_mov_b32 s14, 0x00c0ffff
    s_mov_b32 s15, 0x00c0ffff
    v_cndmask_b32 v40, 0, v61, vcc
    v_cndmask_b32 v41, 0, v61, vcc
    v_pk_mov_b32 v[42:43], v[40:41], v[40:41]
    v_pk_mov_b32 v[44:45], v[40:41], v[40:41]
    v_pk_mov_b32 v[46:47], v[40:41], v[40:41]
    v_pk_mov_b32 v[48:49], v[40:41], v[40:41]
    v_pk_mov_b32 v[50:51], v[40:41], v[40:41]
    v_pk_mov_b32 v[52:53], v[40:41], v[40:41]
    v_pk_mov_b32 v[54:55], v[40:41], v[40:41]
    v_pk_mov_b32 v[168:169], v[40:41], v[40:41]
    v_pk_mov_b32 v[170:171], v[40:41], v[40:41]
    v_pk_mov_b32 v[172:173], v[40:41], v[40:41]
    v_pk_mov_b32 v[174:175], v[40:41], v[40:41]
    v_mfma_f32_32x32x4_2b_bf16 v[120:151], v[10:11], v[10:11], 0
    v_and_b32 v60, 3, v0
    v_bfe_u32 v61, v0, 3, 1
    v_lshl_add_u32 v60, v61, 2, v60
    v_and_b32 v61, 4, v0
    v_lshlrev_b32 v61, 1, v61
    v_sub_u32 v60, v60, v61
    v_add_u32 v60, 8, v60
    v_cmp_lt_u32 vcc, 15, v64
    v_and_b32 v61, 1, v0
    v_add_u32 v61, 16, v61
    v_cndmask_b32 v60, v60, v61, vcc
    v_mul_u32_u24 v62, 18, v65
    s_cmp_lt_u32 s24, 4
    s_cselect_b32 s28, 0, 9216
    s_sub_u32 s29, s27, s28
    s_add_u32 s29, s29, s18
    v_subrev_u32 v61, 4, v60
    v_add_u32 v176, 18, v61
    v_min_u32 v61, v61, v176
    v_add_u32 v61, v61, v62
    v_lshl_add_u32 v3, v61, 4, s18
    v_lshl_add_u32 v176, v61, 4, s29
    v_subrev_u32 v61, 2, v60
    v_add_u32 v177, 18, v61
    v_min_u32 v61, v61, v177
    v_add_u32 v61, v61, v62
    v_add_u32 v61, 72, v61
    v_lshl_add_u32 v177, v61, 4, s29
    v_bfe_u32 v60, v0, 2, 2
    v_lshl_add_u32 v60, v65, 3, v60
    v_mul_u32_u24 v60, 72, v60
    v_and_b32 v61, 1, v0
    v_lshlrev_b32 v61, 4, v61
    v_sub_u32 v60, v60, v61
    v_and_b32 v61, 18, v0
    v_lshlrev_b32 v61, 2, v61
    v_min_u32 v61, 16, v61
    v_add3_u32 v60, v61, v60, s29
    v_add_u32 v61, 16, v60
    v_subrev_u32 v60, 8, v60
    s_mov_b32 vcc_lo, 0xaaaa0000
    s_mov_b32 vcc_hi, 0xaaaa0000
    v_cndmask_b32 v180, v61, v60, vcc
    v_mov_b32 v9, 0x3f80
    v_mov_b32 v13, 0x3f80
    v_mov_b32 v11, 0x420c
    v_mov_b32 v6, 0xdddd
    v_mov_b32 v2, v14
    v_mov_b32 v4, 9216
    v_mov_b32 v5, 9216
    v_add_u32 v58, v2, v4
    v_add_u32 v59, v3, v4
    v_add_u32 v1, 147456, v1
    ds_write_b64 v1, v[58:59]
    v_mov_b32 v178, 18432
    v_mov_b32 v179, 18432
    v_add3_u32 v56, v176, v178, s28
    v_add3_u32 v57, v177, v178, s28
    v_add3_u32 v60, v180, v178, s28
    ds_write_b64 v1, v[56:57] offset:4096
    ds_write_b32 v1, v60 offset:8192
    s_mul_i32 s28, s24, 2304
    v_mul_u32_u24 v181, 36, v64
    v_lshlrev_b32 v61, 4, v65
    v_sub_u32 v181, v181, v61
    v_add3_u32 v181, v181, 16, s28
    v_add_u32 v182, 1152, v181
    v_add_u32 v183, s28, v14
    s_mov_b32 s30, 0x3eae1a93
    s_mov_b32 s31, 0x3eae1a93
    s_mov_b32 s28, 0
    s_mov_b32 m0, 0
    s_mov_b32 s29, 1
    s_mov_b32 s32, 0x8088
    s_mov_b32 s33, 0x80008088
    s_mov_b32 s38, 0x8000ddd0
    s_mov_b32 s39, 0x8000dddc
    s_mov_b32 s34, 0xffff0000
    s_mov_b32 s35, 0x7b800000
    s_mov_b64 vcc, 0
    s_cmp_ge_u32 s24, 4
    s_waitcnt vmcnt(6)
    s_barrier
    s_cbranch_scc0 L_noq
    ds_read_b64_tr_b16 v[152:153], v180 offset:0
    ds_read_b64_tr_b16 v[154:155], v180 offset:288
    ds_read_b64_tr_b16 v[156:157], v180 offset:1152
    ds_read_b64_tr_b16 v[158:159], v180 offset:1440
    ds_read_b64_tr_b16 v[160:161], v180 offset:40
    ds_read_b64_tr_b16 v[162:163], v180 offset:328
    ds_read_b64_tr_b16 v[164:165], v180 offset:1192
    ds_read_b64_tr_b16 v[166:167], v180 offset:1480
    global_load_dword v96, v7, s[4:5] offset:32
    global_load_dwordx4 v[88:91], v186, s[4:5]
    global_load_dwordx4 v[92:95], v186, s[4:5] offset:1152
    s_waitcnt lgkmcnt(0)
    s_mov_b64 exec, s[12:13]
    ds_write_b128 v176, v[152:155] offset:0
    ds_write_b128 v176, v[156:159] offset:576
    s_mov_b64 exec, s[14:15]
    ds_write_b128 v177, v[160:163] offset:0
    ds_write_b128 v177, v[164:167] offset:576
    s_mov_b64 exec, -1
    v_add_u32 v180, 9216, v180
    v_add_u32 v176, 9216, v176
    v_add_u32 v177, 9216, v177
L_noq:
    .p2align 3
    s_waitcnt vmcnt(3) lgkmcnt(0)
    s_barrier
    ds_read_addtid_b32 v12 offset:2048
    ds_read_b128 v[32:35], v2 offset:0
    ds_read_b128 v[36:39], v2 offset:1024
    s_mov_b64 exec, s[12:13]
    s_setprio 3
    ds_read_b128 v[168:171], v3 offset:0
    ds_read_b128 v[172:175], v3 offset:576
    s_mov_b64 exec, -1
    s_waitcnt vmcnt(0)
    v_lshlrev_b32 v114, 16, v96
    v_and_b32 v115, s34, v96
    v_pk_mul_f32 v[114:115], v[114:115], s[30:31]
    v_cvt_pk_bf16_f32 v10, v114, v115
    v_lshlrev_b32 v98, 16, v88
    s_waitcnt lgkmcnt(3)
    v_mfma_f32_32x32x4_2b_bf16 v[56:87], v[12:13], v[10:11], 0 cbsz:1 abid:0
    v_and_b32_e64 v99, s34, v88
    v_lshlrev_b32 v100, 16, v89
    v_and_b32 v101, s34, v89
    v_lshlrev_b32 v102, 16, v90
    v_and_b32 v103, s34, v90
    v_lshlrev_b32 v104, 16, v91
    v_and_b32 v105, s34, v91
    v_lshlrev_b32 v106, 16, v92
    v_and_b32 v107, s34, v92
    v_lshlrev_b32 v108, 16, v93
    v_and_b32 v109, s34, v93
    v_lshlrev_b32 v110, 16, v94
    v_and_b32 v111, s34, v94
    v_lshlrev_b32 v112, 16, v95
    v_and_b32 v113, s34, v95
    v_pk_mul_f32 v[98:99], v[98:99], s[30:31]
    v_pk_mul_f32 v[100:101], v[100:101], s[30:31]
    v_pk_mul_f32 v[102:103], v[102:103], s[30:31]
    v_pk_mul_f32 v[104:105], v[104:105], s[30:31]
    v_pk_mul_f32 v[106:107], v[106:107], s[30:31]
    v_pk_mul_f32 v[108:109], v[108:109], s[30:31]
    v_pk_mul_f32 v[110:111], v[110:111], s[30:31]
    v_pk_mul_f32 v[112:113], v[112:113], s[30:31]
    v_cvt_pk_bf16_f32 v24, v98, v99
    v_cvt_pk_bf16_f32 v25, v100, v101
    v_cvt_pk_bf16_f32 v26, v102, v103
    v_cvt_pk_bf16_f32 v27, v104, v105
    v_cvt_pk_bf16_f32 v28, v106, v107
    v_cvt_pk_bf16_f32 v29, v108, v109
    v_mfma_f32_32x32x16_bf16 v[56:71], v[32:35], v[24:27], v[56:71]
    s_waitcnt lgkmcnt(0)
    v_cvt_pk_bf16_f32 v30, v110, v111
    v_cvt_pk_bf16_f32 v31, v112, v113
    ds_read_addtid_b32 v8 offset:4352
    ds_read_b128 v[16:19], v2 offset:2304
    ds_read_b128 v[20:23], v2 offset:3328
    v_mfma_f32_32x32x16_bf16 v[72:87], v[32:35], v[28:31], v[72:87]
    s_mov_b64 exec, s[12:13]
    ds_read_b128 v[48:51], v3 offset:1152
    ds_read_b128 v[52:55], v3 offset:1728
    ds_read_b128 v[40:43], v3 offset:2304
    ds_read_b128 v[44:47], v3 offset:2880
    s_mov_b64 exec, -1
    s_cbranch_scc1 L_startB
    s_setprio 2
L_first:
    v_exp_f32 v56, v56
    v_exp_f32 v57, v57
    v_exp_f32 v58, v58
    v_exp_f32 v59, v59
    v_exp_f32 v60, v60
    v_mfma_f32_32x32x4_2b_bf16 v[88:119], v[12:13], v[10:11], 0 cbsz:1 abid:1
    v_exp_f32 v61, v61
    v_exp_f32 v62, v62
    v_exp_f32 v63, v63
    v_exp_f32 v64, v64
    v_exp_f32 v65, v65
    v_exp_f32 v66, v66
    v_exp_f32 v67, v67
    v_exp_f32 v68, v68
    v_exp_f32 v69, v69
    v_exp_f32 v70, v70
    v_smfmac_f32_32x32x32_bf16 v[120:135], v[168:171], v[56:63], v6
    v_exp_f32 v71, v71
    v_exp_f32 v72, v72
    v_exp_f32 v73, v73
    v_smfmac_f32_32x32x32_bf16 v[120:135], v[172:175], v[64:71], v6
    v_exp_f32 v74, v74
    v_exp_f32 v75, v75
    v_exp_f32 v76, v76
    v_mfma_f32_32x32x16_bf16 v[88:103], v[36:39], v[24:27], v[88:103]
    v_exp_f32 v77, v77
    v_exp_f32 v78, v78
    v_exp_f32 v79, v79
    v_mfma_f32_32x32x16_bf16 v[104:119], v[36:39], v[28:31], v[104:119]
    v_exp_f32 v80, v80
    v_exp_f32 v81, v81
    v_exp_f32 v82, v82
    v_smfmac_f32_32x32x32_bf16 v[136:151], v[168:171], v[72:79], v6
    s_waitcnt lgkmcnt(0)
    v_exp_f32 v83, v83
    v_exp_f32 v84, v84
    v_exp_f32 v85, v85
    v_exp_f32 v86, v86
    v_exp_f32 v87, v87
    v_exp_f32 v88, v88
    v_exp_f32 v89, v89
    v_smfmac_f32_32x32x32_bf16 v[136:151], v[172:175], v[80:87], v6
    v_exp_f32 v90, v90
    v_exp_f32 v91, v91
    v_exp_f32 v92, v92
    v_mfma_f32_32x32x4_2b_bf16 v[56:87], v[8:9], v[10:11], 0 cbsz:1 abid:0
    v_exp_f32 v93, v93
    v_exp_f32 v94, v94
    v_exp_f32 v95, v95
    v_exp_f32 v96, v96
    v_exp_f32 v97, v97
    v_exp_f32 v98, v98
    v_exp_f32 v99, v99
    v_exp_f32 v100, v100
    v_exp_f32 v101, v101
    v_exp_f32 v102, v102
    v_smfmac_f32_32x32x32_bf16 v[120:135], v[48:51], v[88:95], v6
    v_exp_f32 v103, v103
    v_exp_f32 v104, v104
    v_exp_f32 v105, v105
    v_smfmac_f32_32x32x32_bf16 v[120:135], v[52:55], v[96:103], v6
    v_exp_f32 v106, v106
    v_exp_f32 v107, v107
    v_exp_f32 v108, v108
    v_mfma_f32_32x32x16_bf16 v[56:71], v[16:19], v[24:27], v[56:71]
    v_exp_f32 v109, v109
    v_exp_f32 v110, v110
    v_exp_f32 v111, v111
    v_mfma_f32_32x32x16_bf16 v[72:87], v[16:19], v[28:31], v[72:87]
    v_exp_f32 v112, v112
    v_exp_f32 v113, v113
    v_exp_f32 v114, v114
    v_smfmac_f32_32x32x32_bf16 v[136:151], v[48:51], v[104:111], v6
    v_exp_f32 v115, v115
    v_exp_f32 v116, v116
    v_exp_f32 v117, v117
    v_exp_f32 v118, v118
    v_exp_f32 v119, v119
    v_exp_f32 v56, v56
    v_exp_f32 v57, v57
    v_smfmac_f32_32x32x32_bf16 v[136:151], v[52:55], v[112:119], v6
    v_exp_f32 v58, v58
    v_exp_f32 v59, v59
    v_exp_f32 v60, v60
    v_mfma_f32_32x32x4_2b_bf16 v[88:119], v[8:9], v[10:11], 0 cbsz:1 abid:1
    v_exp_f32 v61, v61
    v_exp_f32 v62, v62
    v_exp_f32 v63, v63
    v_exp_f32 v64, v64
    v_exp_f32 v65, v65
    v_exp_f32 v66, v66
    v_exp_f32 v67, v67
    v_exp_f32 v68, v68
    v_exp_f32 v69, v69
    v_exp_f32 v70, v70
    v_smfmac_f32_32x32x32_bf16 v[120:135], v[40:43], v[56:63], v6
    v_exp_f32 v71, v71
    v_exp_f32 v72, v72
    v_exp_f32 v73, v73
    v_smfmac_f32_32x32x32_bf16 v[120:135], v[44:47], v[64:71], v6
    v_exp_f32 v74, v74
    v_exp_f32 v75, v75
    v_exp_f32 v76, v76
    v_mfma_f32_32x32x16_bf16 v[88:103], v[20:23], v[24:27], v[88:103]
    v_exp_f32 v77, v77
    v_exp_f32 v78, v78
    v_exp_f32 v79, v79
    v_mfma_f32_32x32x16_bf16 v[104:119], v[20:23], v[28:31], v[104:119]
    v_exp_f32 v80, v80
    v_exp_f32 v81, v81
    v_exp_f32 v82, v82
    v_smfmac_f32_32x32x32_bf16 v[136:151], v[40:43], v[72:79], v6
    v_exp_f32 v83, v83
    v_exp_f32 v84, v84
    v_exp_f32 v85, v85
    v_exp_f32 v86, v86
    v_exp_f32 v87, v87
    v_exp_f32 v88, v88
    v_exp_f32 v89, v89
    v_smfmac_f32_32x32x32_bf16 v[136:151], v[44:47], v[80:87], v6
    v_exp_f32 v90, v90
    v_exp_f32 v91, v91
    s_cbranch_scc0 L_topA2
    s_branch L_topB2
L_startB:
    s_setprio 1
    s_add_u32 m0, s27, s18
    s_mov_b64 exec, 0xffff
    buffer_load_dwordx4 v14, s[44:47], s27 offen offset:2048 lds
    s_mov_b64 exec, -1
    buffer_load_dwordx4 v14, s[44:47], s27 offen lds
    buffer_load_dwordx4 v14, s[44:47], s27 offen offset:1024 lds
    s_mov_b32 m0, s27
    s_nop 0
    buffer_load_dwordx4 v184, s[16:19], s27 offen lds
    s_add_u32 m0, s27, 988
    s_nop 0
    buffer_load_dwordx4 v184, s[16:19], s27 offen offset:36 lds
    s_add_u32 m0, s27, 2016
    s_nop 0
    buffer_load_dword v185, s[16:19], s27 offen offset:32 lds
    s_mov_b32 m0, s28
    s_add_u32 s27, s27, 18432
    s_cmp_ge_u32 s24, 4
    s_branch L_first
L_evR:
    s_waitcnt vmcnt(0)
    ds_read_b64_tr_b16 v[152:153], v180 offset:0
    ds_read_b64_tr_b16 v[154:155], v180 offset:288
    ds_read_b64_tr_b16 v[156:157], v180 offset:1152
    ds_read_b64_tr_b16 v[158:159], v180 offset:1440
    ds_read_b64_tr_b16 v[160:161], v180 offset:40
    ds_read_b64_tr_b16 v[162:163], v180 offset:328
    ds_read_b64_tr_b16 v[164:165], v180 offset:1192
    ds_read_b64_tr_b16 v[166:167], v180 offset:1480
    s_cmp_ge_u32 s24, 4
    s_cbranch_scc0 L_backA2
    s_branch L_backB2
L_evW:
    s_cmp_eq_u32 s29, 31
    s_cbranch_scc1 L_ev31
    s_mov_b64 exec, s[12:13]
    ds_write_b128 v176, v[152:155] offset:0
    ds_write_b128 v176, v[156:159] offset:576
    s_mov_b64 exec, s[14:15]
    ds_write_b128 v177, v[160:163] offset:0
    ds_write_b128 v177, v[164:167] offset:576
    s_mov_b64 exec, -1
    ds_add_rtn_u64 v[176:177], v1, v[178:179] offset:4096
    ds_add_rtn_u32 v180, v1, v178 offset:8192
    s_cmp_ge_u32 s24, 4
    s_cbranch_scc0 L_backA3
    s_branch L_backB3
L_evD:
    s_add_u32 m0, s27, s18
    s_mov_b64 exec, 0xffff
    buffer_load_dwordx4 v14, s[44:47], s27 offen offset:2048 lds
    s_mov_b64 exec, -1
    buffer_load_dwordx4 v14, s[44:47], s27 offen lds
    buffer_load_dwordx4 v14, s[44:47], s27 offen offset:1024 lds
    s_mov_b32 m0, s27
    s_nop 0
    buffer_load_dwordx4 v184, s[16:19], s27 offen lds
    s_add_u32 m0, s27, 988
    s_nop 0
    buffer_load_dwordx4 v184, s[16:19], s27 offen offset:36 lds
    s_add_u32 m0, s27, 2016
    s_nop 0
    buffer_load_dword v185, s[16:19], s27 offen offset:32 lds
    s_mov_b32 m0, s28
    s_add_u32 s27, s27, 18432
    s_cmp_ge_u32 s24, 4
    s_cbranch_scc0 L_backA0
    s_branch L_backB0
L_ev31:
    s_mov_b64 vcc, 1
    s_mov_b64 exec, s[12:13]
    ds_read_b128 v[168:171], v3 offset:8064
    ds_read_b128 v[172:175], v3 offset:8640
    s_mov_b64 exec, -1
    s_cmp_ge_u32 s24, 4
    s_cbranch_scc0 L_backA3
    s_branch L_backB3
    .p2align 6
L_topA0:
    s_setprio 0
    s_add_u32 s29, s29, 1
    ds_read_addtid_b32 v8 offset:11264
    ds_read_b128 v[16:19], v2 offset:9216
    ds_read_b128 v[20:23], v2 offset:10240
    s_mov_b64 exec, s[12:13]
    ds_read_b128 v[48:51], v3 offset:8064
    ds_read_b128 v[52:55], v3 offset:8640
    ds_read_b128 v[40:43], v3 offset:9216
    ds_read_b128 v[44:47], v3 offset:9792
    s_mov_b64 exec, -1
    ds_add_rtn_u64 v[2:3], v1, v[4:5]
    s_addk_i32 s28, 9216
    s_mov_b32 m0, s28
    s_bitcmp1_b32 s38, s29
    s_cbranch_scc1 L_evD
L_backA0:
    s_waitcnt lgkmcnt(0)
L_segA0:
    v_exp_f32 v92, v92
    v_mfma_f32_32x32x4_2b_bf16 v[56:87], v[8:9], v[10:11], 0 cbsz:1 abid:0
    v_exp_f32 v93, v93
    v_exp_f32 v94, v94
    v_exp_f32 v95, v95
    v_exp_f32 v96, v96
    v_exp_f32 v97, v97
    v_exp_f32 v98, v98
    v_exp_f32 v99, v99
    v_exp_f32 v100, v100
    v_exp_f32 v101, v101
    v_exp_f32 v102, v102
    v_smfmac_f32_32x32x32_bf16 v[120:135], v[48:51], v[88:95], v6
    s_setprio 2
    v_exp_f32 v103, v103
    v_exp_f32 v104, v104
    v_exp_f32 v105, v105
    v_smfmac_f32_32x32x32_bf16 v[120:135], v[52:55], v[96:103], v6
    v_exp_f32 v106, v106
    v_exp_f32 v107, v107
    v_exp_f32 v108, v108
    v_mfma_f32_32x32x16_bf16 v[56:71], v[16:19], v[24:27], v[56:71]
    v_exp_f32 v109, v109
    v_exp_f32 v110, v110
    v_exp_f32 v111, v111
    v_mfma_f32_32x32x16_bf16 v[72:87], v[16:19], v[28:31], v[72:87]
    v_exp_f32 v112, v112
    v_exp_f32 v113, v113
    v_exp_f32 v114, v114
    v_smfmac_f32_32x32x32_bf16 v[136:151], v[48:51], v[104:111], v6
    v_exp_f32 v115, v115
    v_exp_f32 v116, v116
    v_exp_f32 v117, v117
    v_exp_f32 v118, v118
    v_exp_f32 v119, v119
    v_exp_f32 v56, v56
    v_exp_f32 v57, v57
    v_smfmac_f32_32x32x32_bf16 v[136:151], v[52:55], v[112:119], v6
    v_exp_f32 v58, v58
    v_exp_f32 v59, v59
    v_exp_f32 v60, v60
    v_mfma_f32_32x32x4_2b_bf16 v[88:119], v[8:9], v[10:11], 0 cbsz:1 abid:1
    v_exp_f32 v61, v61
    v_exp_f32 v62, v62
    v_exp_f32 v63, v63
    v_exp_f32 v64, v64
    v_exp_f32 v65, v65
    v_exp_f32 v66, v66
    v_exp_f32 v67, v67
    v_exp_f32 v68, v68
    v_exp_f32 v69, v69
    v_exp_f32 v70, v70
    v_smfmac_f32_32x32x32_bf16 v[120:135], v[40:43], v[56:63], v6
    v_exp_f32 v71, v71
    v_exp_f32 v72, v72
    v_exp_f32 v73, v73
    v_smfmac_f32_32x32x32_bf16 v[120:135], v[44:47], v[64:71], v6
    v_exp_f32 v74, v74
    v_exp_f32 v75, v75
    v_exp_f32 v76, v76
    v_mfma_f32_32x32x16_bf16 v[88:103], v[20:23], v[24:27], v[88:103]
    v_exp_f32 v77, v77
    v_exp_f32 v78, v78
    v_exp_f32 v79, v79
    v_mfma_f32_32x32x16_bf16 v[104:119], v[20:23], v[28:31], v[104:119]
    v_exp_f32 v80, v80
    v_exp_f32 v81, v81
    v_exp_f32 v82, v82
    v_smfmac_f32_32x32x32_bf16 v[136:151], v[40:43], v[72:79], v6
    v_exp_f32 v83, v83
    v_exp_f32 v84, v84
    v_exp_f32 v85, v85
    v_exp_f32 v86, v86
    v_exp_f32 v87, v87
    v_exp_f32 v88, v88
    v_exp_f32 v89, v89
    v_smfmac_f32_32x32x32_bf16 v[136:151], v[44:47], v[80:87], v6
    v_exp_f32 v90, v90
    v_exp_f32 v91, v91
L_topA1:
    s_setprio 0
    s_add_u32 s29, s29, 1
    ds_read_addtid_b32 v8 offset:4352
    ds_read_b128 v[16:19], v2 offset:2304
    ds_read_b128 v[20:23], v2 offset:3328
    s_mov_b64 exec, s[12:13]
    ds_read_b128 v[48:51], v3 offset:1152
    ds_read_b128 v[52:55], v3 offset:1728
    ds_read_b128 v[40:43], v3 offset:2304
    ds_read_b128 v[44:47], v3 offset:2880
    s_mov_b64 exec, -1
L_backA1:
    s_waitcnt lgkmcnt(0)
L_segA1:
    v_exp_f32 v92, v92
    v_mfma_f32_32x32x4_2b_bf16 v[56:87], v[8:9], v[10:11], 0 cbsz:1 abid:0
    v_exp_f32 v93, v93
    v_exp_f32 v94, v94
    v_exp_f32 v95, v95
    v_exp_f32 v96, v96
    v_exp_f32 v97, v97
    v_exp_f32 v98, v98
    v_exp_f32 v99, v99
    v_exp_f32 v100, v100
    v_exp_f32 v101, v101
    v_exp_f32 v102, v102
    v_smfmac_f32_32x32x32_bf16 v[120:135], v[48:51], v[88:95], v6
    s_setprio 2
    v_exp_f32 v103, v103
    v_exp_f32 v104, v104
    v_exp_f32 v105, v105
    v_smfmac_f32_32x32x32_bf16 v[120:135], v[52:55], v[96:103], v6
    v_exp_f32 v106, v106
    v_exp_f32 v107, v107
    v_exp_f32 v108, v108
    v_mfma_f32_32x32x16_bf16 v[56:71], v[16:19], v[24:27], v[56:71]
    v_exp_f32 v109, v109
    v_exp_f32 v110, v110
    v_exp_f32 v111, v111
    v_mfma_f32_32x32x16_bf16 v[72:87], v[16:19], v[28:31], v[72:87]
    v_exp_f32 v112, v112
    v_exp_f32 v113, v113
    v_exp_f32 v114, v114
    v_smfmac_f32_32x32x32_bf16 v[136:151], v[48:51], v[104:111], v6
    v_exp_f32 v115, v115
    v_exp_f32 v116, v116
    v_exp_f32 v117, v117
    v_exp_f32 v118, v118
    v_exp_f32 v119, v119
    v_exp_f32 v56, v56
    v_exp_f32 v57, v57
    v_smfmac_f32_32x32x32_bf16 v[136:151], v[52:55], v[112:119], v6
    v_exp_f32 v58, v58
    v_exp_f32 v59, v59
    v_exp_f32 v60, v60
    v_mfma_f32_32x32x4_2b_bf16 v[88:119], v[8:9], v[10:11], 0 cbsz:1 abid:1
    v_exp_f32 v61, v61
    v_exp_f32 v62, v62
    v_exp_f32 v63, v63
    v_exp_f32 v64, v64
    v_exp_f32 v65, v65
    v_exp_f32 v66, v66
    v_exp_f32 v67, v67
    v_exp_f32 v68, v68
    v_exp_f32 v69, v69
    v_exp_f32 v70, v70
    v_smfmac_f32_32x32x32_bf16 v[120:135], v[40:43], v[56:63], v6
    v_exp_f32 v71, v71
    v_exp_f32 v72, v72
    v_exp_f32 v73, v73
    v_smfmac_f32_32x32x32_bf16 v[120:135], v[44:47], v[64:71], v6
    v_exp_f32 v74, v74
    v_exp_f32 v75, v75
    v_exp_f32 v76, v76
    v_mfma_f32_32x32x16_bf16 v[88:103], v[20:23], v[24:27], v[88:103]
    v_exp_f32 v77, v77
    v_exp_f32 v78, v78
    v_exp_f32 v79, v79
    v_mfma_f32_32x32x16_bf16 v[104:119], v[20:23], v[28:31], v[104:119]
    v_exp_f32 v80, v80
    v_exp_f32 v81, v81
    v_exp_f32 v82, v82
    v_smfmac_f32_32x32x32_bf16 v[136:151], v[40:43], v[72:79], v6
    v_exp_f32 v83, v83
    v_exp_f32 v84, v84
    v_exp_f32 v85, v85
    v_exp_f32 v86, v86
    v_exp_f32 v87, v87
    v_exp_f32 v88, v88
    v_exp_f32 v89, v89
    v_smfmac_f32_32x32x32_bf16 v[136:151], v[44:47], v[80:87], v6
    v_exp_f32 v90, v90
    v_exp_f32 v91, v91
L_topA2:
    s_setprio 0
    s_add_u32 s29, s29, 1
    ds_read_addtid_b32 v8 offset:6656
    ds_read_b128 v[16:19], v2 offset:4608
    ds_read_b128 v[20:23], v2 offset:5632
    s_mov_b64 exec, s[12:13]
    ds_read_b128 v[48:51], v3 offset:3456
    ds_read_b128 v[52:55], v3 offset:4032
    ds_read_b128 v[40:43], v3 offset:4608
    ds_read_b128 v[44:47], v3 offset:5184
    s_mov_b64 exec, -1
    s_bitcmp1_b32 s38, s29
    s_cbranch_scc1 L_evR
L_backA2:
    s_waitcnt lgkmcnt(0)
L_segA2:
    v_exp_f32 v92, v92
    v_mfma_f32_32x32x4_2b_bf16 v[56:87], v[8:9], v[10:11], 0 cbsz:1 abid:0
    v_exp_f32 v93, v93
    v_exp_f32 v94, v94
    v_exp_f32 v95, v95
    v_exp_f32 v96, v96
    v_exp_f32 v97, v97
    v_exp_f32 v98, v98
    v_exp_f32 v99, v99
    v_exp_f32 v100, v100
    v_exp_f32 v101, v101
    v_exp_f32 v102, v102
    v_smfmac_f32_32x32x32_bf16 v[120:135], v[48:51], v[88:95], v6
    s_setprio 2
    v_exp_f32 v103, v103
    v_exp_f32 v104, v104
    v_exp_f32 v105, v105
    v_smfmac_f32_32x32x32_bf16 v[120:135], v[52:55], v[96:103], v6
    v_exp_f32 v106, v106
    v_exp_f32 v107, v107
    v_exp_f32 v108, v108
    v_mfma_f32_32x32x16_bf16 v[56:71], v[16:19], v[24:27], v[56:71]
    v_exp_f32 v109, v109
    v_exp_f32 v110, v110
    v_exp_f32 v111, v111
    v_mfma_f32_32x32x16_bf16 v[72:87], v[16:19], v[28:31], v[72:87]
    v_exp_f32 v112, v112
    v_exp_f32 v113, v113
    v_exp_f32 v114, v114
    v_smfmac_f32_32x32x32_bf16 v[136:151], v[48:51], v[104:111], v6
    v_exp_f32 v115, v115
    v_exp_f32 v116, v116
    v_exp_f32 v117, v117
    v_exp_f32 v118, v118
    v_exp_f32 v119, v119
    v_exp_f32 v56, v56
    v_exp_f32 v57, v57
    v_smfmac_f32_32x32x32_bf16 v[136:151], v[52:55], v[112:119], v6
    v_exp_f32 v58, v58
    v_exp_f32 v59, v59
    v_exp_f32 v60, v60
    v_mfma_f32_32x32x4_2b_bf16 v[88:119], v[8:9], v[10:11], 0 cbsz:1 abid:1
    v_exp_f32 v61, v61
    v_exp_f32 v62, v62
    v_exp_f32 v63, v63
    v_exp_f32 v64, v64
    v_exp_f32 v65, v65
    v_exp_f32 v66, v66
    v_exp_f32 v67, v67
    v_exp_f32 v68, v68
    v_exp_f32 v69, v69
    v_exp_f32 v70, v70
    v_smfmac_f32_32x32x32_bf16 v[120:135], v[40:43], v[56:63], v6
    v_exp_f32 v71, v71
    v_exp_f32 v72, v72
    v_exp_f32 v73, v73
    v_smfmac_f32_32x32x32_bf16 v[120:135], v[44:47], v[64:71], v6
    v_exp_f32 v74, v74
    v_exp_f32 v75, v75
    v_exp_f32 v76, v76
    v_mfma_f32_32x32x16_bf16 v[88:103], v[20:23], v[24:27], v[88:103]
    v_exp_f32 v77, v77
    v_exp_f32 v78, v78
    v_exp_f32 v79, v79
    v_mfma_f32_32x32x16_bf16 v[104:119], v[20:23], v[28:31], v[104:119]
    v_exp_f32 v80, v80
    v_exp_f32 v81, v81
    v_exp_f32 v82, v82
    v_smfmac_f32_32x32x32_bf16 v[136:151], v[40:43], v[72:79], v6
    v_exp_f32 v83, v83
    v_exp_f32 v84, v84
    v_exp_f32 v85, v85
    v_exp_f32 v86, v86
    v_exp_f32 v87, v87
    v_exp_f32 v88, v88
    v_exp_f32 v89, v89
    v_smfmac_f32_32x32x32_bf16 v[136:151], v[44:47], v[80:87], v6
    v_exp_f32 v90, v90
    v_exp_f32 v91, v91
L_topA3:
    s_setprio 0
    s_add_u32 s29, s29, 1
    ds_read_addtid_b32 v8 offset:8960
    ds_read_b128 v[16:19], v2 offset:6912
    ds_read_b128 v[20:23], v2 offset:7936
    s_mov_b64 exec, s[12:13]
    ds_read_b128 v[48:51], v3 offset:5760
    ds_read_b128 v[52:55], v3 offset:6336
    ds_read_b128 v[40:43], v3 offset:6912
    ds_read_b128 v[44:47], v3 offset:7488
    s_mov_b64 exec, -1
    s_bitcmp1_b32 s38, s29
    s_cbranch_scc1 L_evW
L_backA3:
    s_bitcmp1_b32 s33, s29
    s_waitcnt lgkmcnt(0)
L_segA3:
    v_exp_f32 v92, v92
    v_mfma_f32_32x32x4_2b_bf16 v[56:87], v[8:9], v[10:11], 0 cbsz:1 abid:0
    v_exp_f32 v93, v93
    v_exp_f32 v94, v94
    v_exp_f32 v95, v95
    v_exp_f32 v96, v96
    v_exp_f32 v97, v97
    v_exp_f32 v98, v98
    v_exp_f32 v99, v99
    v_exp_f32 v100, v100
    v_exp_f32 v101, v101
    v_exp_f32 v102, v102
    v_smfmac_f32_32x32x32_bf16 v[120:135], v[48:51], v[88:95], v6
    s_setprio 2
    v_exp_f32 v103, v103
    v_exp_f32 v104, v104
    v_exp_f32 v105, v105
    v_smfmac_f32_32x32x32_bf16 v[120:135], v[52:55], v[96:103], v6
    v_exp_f32 v106, v106
    v_exp_f32 v107, v107
    v_exp_f32 v108, v108
    v_mfma_f32_32x32x16_bf16 v[56:71], v[16:19], v[24:27], v[56:71]
    v_exp_f32 v109, v109
    v_exp_f32 v110, v110
    v_exp_f32 v111, v111
    v_mfma_f32_32x32x16_bf16 v[72:87], v[16:19], v[28:31], v[72:87]
    v_exp_f32 v112, v112
    v_exp_f32 v113, v113
    v_exp_f32 v114, v114
    v_smfmac_f32_32x32x32_bf16 v[136:151], v[48:51], v[104:111], v6
    v_exp_f32 v115, v115
    v_exp_f32 v116, v116
    v_exp_f32 v117, v117
    v_exp_f32 v118, v118
    v_exp_f32 v119, v119
    v_exp_f32 v56, v56
    v_exp_f32 v57, v57
    v_smfmac_f32_32x32x32_bf16 v[136:151], v[52:55], v[112:119], v6
    v_exp_f32 v58, v58
    v_exp_f32 v59, v59
    v_exp_f32 v60, v60
    v_mfma_f32_32x32x4_2b_bf16 v[88:119], v[8:9], v[10:11], 0 cbsz:1 abid:1
    v_exp_f32 v61, v61
    v_exp_f32 v62, v62
    v_exp_f32 v63, v63
    v_exp_f32 v64, v64
    v_exp_f32 v65, v65
    v_exp_f32 v66, v66
    v_exp_f32 v67, v67
    v_exp_f32 v68, v68
    v_exp_f32 v69, v69
    v_exp_f32 v70, v70
    v_smfmac_f32_32x32x32_bf16 v[120:135], v[40:43], v[56:63], v6
    v_exp_f32 v71, v71
    v_exp_f32 v72, v72
    v_exp_f32 v73, v73
    v_smfmac_f32_32x32x32_bf16 v[120:135], v[44:47], v[64:71], v6
    v_exp_f32 v74, v74
    v_exp_f32 v75, v75
    v_exp_f32 v76, v76
    v_mfma_f32_32x32x16_bf16 v[88:103], v[20:23], v[24:27], v[88:103]
    v_exp_f32 v77, v77
    v_exp_f32 v78, v78
    v_exp_f32 v79, v79
    v_mfma_f32_32x32x16_bf16 v[104:119], v[20:23], v[28:31], v[104:119]
    v_exp_f32 v80, v80
    v_exp_f32 v81, v81
    v_exp_f32 v82, v82
    v_smfmac_f32_32x32x32_bf16 v[136:151], v[40:43], v[72:79], v6
    v_exp_f32 v83, v83
    v_exp_f32 v84, v84
    v_exp_f32 v85, v85
    v_exp_f32 v86, v86
    v_exp_f32 v87, v87
    v_exp_f32 v88, v88
    v_exp_f32 v89, v89
    v_smfmac_f32_32x32x32_bf16 v[136:151], v[44:47], v[80:87], v6
    v_exp_f32 v90, v90
    v_exp_f32 v91, v91
    s_cbranch_scc0 L_topA0
    s_cbranch_vccnz L_tail
    s_barrier
    s_branch L_topA0
    .p2align 6
    .fill 1, 4, 0xbf800000
L_topB0:
    s_add_u32 s29, s29, 1
    ds_read_addtid_b32 v8 offset:11264
    ds_read_b128 v[16:19], v2 offset:9216
    ds_read_b128 v[20:23], v2 offset:10240
    s_mov_b64 exec, s[12:13]
    ds_read_b128 v[48:51], v3 offset:8064
    ds_read_b128 v[52:55], v3 offset:8640
    ds_read_b128 v[40:43], v3 offset:9216
    ds_read_b128 v[44:47], v3 offset:9792
    s_mov_b64 exec, -1
    ds_add_rtn_u64 v[2:3], v1, v[4:5]
    s_addk_i32 s28, 9216
    s_mov_b32 m0, s28
    s_bitcmp1_b32 s39, s29
    s_cbranch_scc1 L_evD
L_backB0:
    s_waitcnt lgkmcnt(0)
L_segB0:
    v_exp_f32 v92, v92
    v_mfma_f32_32x32x4_2b_bf16 v[56:87], v[8:9], v[10:11], 0 cbsz:1 abid:0
    v_exp_f32 v93, v93
    v_exp_f32 v94, v94
    v_exp_f32 v95, v95
    v_exp_f32 v96, v96
    v_exp_f32 v97, v97
    v_exp_f32 v98, v98
    v_exp_f32 v99, v99
    v_exp_f32 v100, v100
    v_exp_f32 v101, v101
    v_exp_f32 v102, v102
    v_smfmac_f32_32x32x32_bf16 v[120:135], v[48:51], v[88:95], v6
    v_exp_f32 v103, v103
    v_exp_f32 v104, v104
    v_exp_f32 v105, v105
    v_smfmac_f32_32x32x32_bf16 v[120:135], v[52:55], v[96:103], v6
    v_exp_f32 v106, v106
    v_exp_f32 v107, v107
    v_exp_f32 v108, v108
    v_mfma_f32_32x32x16_bf16 v[56:71], v[16:19], v[24:27], v[56:71]
    v_exp_f32 v109, v109
    v_exp_f32 v110, v110
    v_exp_f32 v111, v111
    v_mfma_f32_32x32x16_bf16 v[72:87], v[16:19], v[28:31], v[72:87]
    v_exp_f32 v112, v112
    v_exp_f32 v113, v113
    v_exp_f32 v114, v114
    v_smfmac_f32_32x32x32_bf16 v[136:151], v[48:51], v[104:111], v6
    v_exp_f32 v115, v115
    v_exp_f32 v116, v116
    v_exp_f32 v117, v117
    v_exp_f32 v118, v118
    v_exp_f32 v119, v119
    v_exp_f32 v56, v56
    v_exp_f32 v57, v57
    v_smfmac_f32_32x32x32_bf16 v[136:151], v[52:55], v[112:119], v6
    v_exp_f32 v58, v58
    v_exp_f32 v59, v59
    v_exp_f32 v60, v60
    v_mfma_f32_32x32x4_2b_bf16 v[88:119], v[8:9], v[10:11], 0 cbsz:1 abid:1
    v_exp_f32 v61, v61
    v_exp_f32 v62, v62
    v_exp_f32 v63, v63
    v_exp_f32 v64, v64
    v_exp_f32 v65, v65
    v_exp_f32 v66, v66
    v_exp_f32 v67, v67
    v_exp_f32 v68, v68
    v_exp_f32 v69, v69
    v_exp_f32 v70, v70
    v_smfmac_f32_32x32x32_bf16 v[120:135], v[40:43], v[56:63], v6
    v_exp_f32 v71, v71
    v_exp_f32 v72, v72
    v_exp_f32 v73, v73
    v_smfmac_f32_32x32x32_bf16 v[120:135], v[44:47], v[64:71], v6
    v_exp_f32 v74, v74
    v_exp_f32 v75, v75
    v_exp_f32 v76, v76
    v_mfma_f32_32x32x16_bf16 v[88:103], v[20:23], v[24:27], v[88:103]
    v_exp_f32 v77, v77
    v_exp_f32 v78, v78
    v_exp_f32 v79, v79
    v_mfma_f32_32x32x16_bf16 v[104:119], v[20:23], v[28:31], v[104:119]
    v_exp_f32 v80, v80
    v_exp_f32 v81, v81
    v_exp_f32 v82, v82
    v_smfmac_f32_32x32x32_bf16 v[136:151], v[40:43], v[72:79], v6
    v_exp_f32 v83, v83
    v_exp_f32 v84, v84
    v_exp_f32 v85, v85
    v_exp_f32 v86, v86
    v_exp_f32 v87, v87
    v_exp_f32 v88, v88
    v_exp_f32 v89, v89
    v_smfmac_f32_32x32x32_bf16 v[136:151], v[44:47], v[80:87], v6
    v_exp_f32 v90, v90
    v_exp_f32 v91, v91
L_topB1:
    s_add_u32 s29, s29, 1
    ds_read_addtid_b32 v8 offset:4352
    ds_read_b128 v[16:19], v2 offset:2304
    ds_read_b128 v[20:23], v2 offset:3328
    s_mov_b64 exec, s[12:13]
    ds_read_b128 v[48:51], v3 offset:1152
    ds_read_b128 v[52:55], v3 offset:1728
    ds_read_b128 v[40:43], v3 offset:2304
    ds_read_b128 v[44:47], v3 offset:2880
    s_mov_b64 exec, -1
L_backB1:
    s_waitcnt lgkmcnt(0)
L_segB1:
    v_exp_f32 v92, v92
    v_mfma_f32_32x32x4_2b_bf16 v[56:87], v[8:9], v[10:11], 0 cbsz:1 abid:0
    v_exp_f32 v93, v93
    v_exp_f32 v94, v94
    v_exp_f32 v95, v95
    v_exp_f32 v96, v96
    v_exp_f32 v97, v97
    v_exp_f32 v98, v98
    v_exp_f32 v99, v99
    v_exp_f32 v100, v100
    v_exp_f32 v101, v101
    v_exp_f32 v102, v102
    v_smfmac_f32_32x32x32_bf16 v[120:135], v[48:51], v[88:95], v6
    v_exp_f32 v103, v103
    v_exp_f32 v104, v104
    v_exp_f32 v105, v105
    v_smfmac_f32_32x32x32_bf16 v[120:135], v[52:55], v[96:103], v6
    v_exp_f32 v106, v106
    v_exp_f32 v107, v107
    v_exp_f32 v108, v108
    v_mfma_f32_32x32x16_bf16 v[56:71], v[16:19], v[24:27], v[56:71]
    v_exp_f32 v109, v109
    v_exp_f32 v110, v110
    v_exp_f32 v111, v111
    v_mfma_f32_32x32x16_bf16 v[72:87], v[16:19], v[28:31], v[72:87]
    v_exp_f32 v112, v112
    v_exp_f32 v113, v113
    v_exp_f32 v114, v114
    v_smfmac_f32_32x32x32_bf16 v[136:151], v[48:51], v[104:111], v6
    v_exp_f32 v115, v115
    v_exp_f32 v116, v116
    v_exp_f32 v117, v117
    v_exp_f32 v118, v118
    v_exp_f32 v119, v119
    v_exp_f32 v56, v56
    v_exp_f32 v57, v57
    v_smfmac_f32_32x32x32_bf16 v[136:151], v[52:55], v[112:119], v6
    v_exp_f32 v58, v58
    v_exp_f32 v59, v59
    v_exp_f32 v60, v60
    v_mfma_f32_32x32x4_2b_bf16 v[88:119], v[8:9], v[10:11], 0 cbsz:1 abid:1
    v_exp_f32 v61, v61
    v_exp_f32 v62, v62
    v_exp_f32 v63, v63
    v_exp_f32 v64, v64
    v_exp_f32 v65, v65
    v_exp_f32 v66, v66
    v_exp_f32 v67, v67
    v_exp_f32 v68, v68
    v_exp_f32 v69, v69
    v_exp_f32 v70, v70
    v_smfmac_f32_32x32x32_bf16 v[120:135], v[40:43], v[56:63], v6
    v_exp_f32 v71, v71
    v_exp_f32 v72, v72
    v_exp_f32 v73, v73
    v_smfmac_f32_32x32x32_bf16 v[120:135], v[44:47], v[64:71], v6
    v_exp_f32 v74, v74
    v_exp_f32 v75, v75
    v_exp_f32 v76, v76
    v_mfma_f32_32x32x16_bf16 v[88:103], v[20:23], v[24:27], v[88:103]
    v_exp_f32 v77, v77
    v_exp_f32 v78, v78
    v_exp_f32 v79, v79
    v_mfma_f32_32x32x16_bf16 v[104:119], v[20:23], v[28:31], v[104:119]
    v_exp_f32 v80, v80
    v_exp_f32 v81, v81
    v_exp_f32 v82, v82
    v_smfmac_f32_32x32x32_bf16 v[136:151], v[40:43], v[72:79], v6
    v_exp_f32 v83, v83
    v_exp_f32 v84, v84
    v_exp_f32 v85, v85
    v_exp_f32 v86, v86
    v_exp_f32 v87, v87
    v_exp_f32 v88, v88
    v_exp_f32 v89, v89
    v_smfmac_f32_32x32x32_bf16 v[136:151], v[44:47], v[80:87], v6
    v_exp_f32 v90, v90
    v_exp_f32 v91, v91
L_topB2:
    s_add_u32 s29, s29, 1
    ds_read_addtid_b32 v8 offset:6656
    ds_read_b128 v[16:19], v2 offset:4608
    ds_read_b128 v[20:23], v2 offset:5632
    s_mov_b64 exec, s[12:13]
    ds_read_b128 v[48:51], v3 offset:3456
    ds_read_b128 v[52:55], v3 offset:4032
    ds_read_b128 v[40:43], v3 offset:4608
    ds_read_b128 v[44:47], v3 offset:5184
    s_mov_b64 exec, -1
    s_bitcmp1_b32 s39, s29
    s_cbranch_scc1 L_evR
L_backB2:
    s_waitcnt lgkmcnt(0)
L_segB2:
    v_exp_f32 v92, v92
    v_mfma_f32_32x32x4_2b_bf16 v[56:87], v[8:9], v[10:11], 0 cbsz:1 abid:0
    v_exp_f32 v93, v93
    v_exp_f32 v94, v94
    v_exp_f32 v95, v95
    v_exp_f32 v96, v96
    v_exp_f32 v97, v97
    v_exp_f32 v98, v98
    v_exp_f32 v99, v99
    v_exp_f32 v100, v100
    v_exp_f32 v101, v101
    v_exp_f32 v102, v102
    v_smfmac_f32_32x32x32_bf16 v[120:135], v[48:51], v[88:95], v6
    v_exp_f32 v103, v103
    v_exp_f32 v104, v104
    v_exp_f32 v105, v105
    v_smfmac_f32_32x32x32_bf16 v[120:135], v[52:55], v[96:103], v6
    v_exp_f32 v106, v106
    v_exp_f32 v107, v107
    v_exp_f32 v108, v108
    v_mfma_f32_32x32x16_bf16 v[56:71], v[16:19], v[24:27], v[56:71]
    v_exp_f32 v109, v109
    v_exp_f32 v110, v110
    v_exp_f32 v111, v111
    v_mfma_f32_32x32x16_bf16 v[72:87], v[16:19], v[28:31], v[72:87]
    v_exp_f32 v112, v112
    v_exp_f32 v113, v113
    v_exp_f32 v114, v114
    v_smfmac_f32_32x32x32_bf16 v[136:151], v[48:51], v[104:111], v6
    v_exp_f32 v115, v115
    v_exp_f32 v116, v116
    v_exp_f32 v117, v117
    v_exp_f32 v118, v118
    v_exp_f32 v119, v119
    v_exp_f32 v56, v56
    v_exp_f32 v57, v57
    v_smfmac_f32_32x32x32_bf16 v[136:151], v[52:55], v[112:119], v6
    v_exp_f32 v58, v58
    v_exp_f32 v59, v59
    v_exp_f32 v60, v60
    v_mfma_f32_32x32x4_2b_bf16 v[88:119], v[8:9], v[10:11], 0 cbsz:1 abid:1
    v_exp_f32 v61, v61
    v_exp_f32 v62, v62
    v_exp_f32 v63, v63
    v_exp_f32 v64, v64
    v_exp_f32 v65, v65
    v_exp_f32 v66, v66
    v_exp_f32 v67, v67
    v_exp_f32 v68, v68
    v_exp_f32 v69, v69
    v_exp_f32 v70, v70
    v_smfmac_f32_32x32x32_bf16 v[120:135], v[40:43], v[56:63], v6
    v_exp_f32 v71, v71
    v_exp_f32 v72, v72
    v_exp_f32 v73, v73
    v_smfmac_f32_32x32x32_bf16 v[120:135], v[44:47], v[64:71], v6
    v_exp_f32 v74, v74
    v_exp_f32 v75, v75
    v_exp_f32 v76, v76
    v_mfma_f32_32x32x16_bf16 v[88:103], v[20:23], v[24:27], v[88:103]
    v_exp_f32 v77, v77
    v_exp_f32 v78, v78
    v_exp_f32 v79, v79
    v_mfma_f32_32x32x16_bf16 v[104:119], v[20:23], v[28:31], v[104:119]
    v_exp_f32 v80, v80
    v_exp_f32 v81, v81
    v_exp_f32 v82, v82
    v_smfmac_f32_32x32x32_bf16 v[136:151], v[40:43], v[72:79], v6
    v_exp_f32 v83, v83
    v_exp_f32 v84, v84
    v_exp_f32 v85, v85
    v_exp_f32 v86, v86
    v_exp_f32 v87, v87
    v_exp_f32 v88, v88
    v_exp_f32 v89, v89
    v_smfmac_f32_32x32x32_bf16 v[136:151], v[44:47], v[80:87], v6
    v_exp_f32 v90, v90
    v_exp_f32 v91, v91
L_topB3:
    s_add_u32 s29, s29, 1
    ds_read_addtid_b32 v8 offset:8960
    ds_read_b128 v[16:19], v2 offset:6912
    ds_read_b128 v[20:23], v2 offset:7936
    s_mov_b64 exec, s[12:13]
    ds_read_b128 v[48:51], v3 offset:5760
    ds_read_b128 v[52:55], v3 offset:6336
    ds_read_b128 v[40:43], v3 offset:6912
    ds_read_b128 v[44:47], v3 offset:7488
    s_mov_b64 exec, -1
    s_bitcmp1_b32 s39, s29
    s_cbranch_scc1 L_evW
L_backB3:
    s_bitcmp1_b32 s32, s29
    s_waitcnt lgkmcnt(0)
    s_cbranch_scc0 L_segB3
    s_barrier
L_segB3:
    v_exp_f32 v92, v92
    v_mfma_f32_32x32x4_2b_bf16 v[56:87], v[8:9], v[10:11], 0 cbsz:1 abid:0
    v_exp_f32 v93, v93
    v_exp_f32 v94, v94
    v_exp_f32 v95, v95
    v_exp_f32 v96, v96
    v_exp_f32 v97, v97
    v_exp_f32 v98, v98
    v_exp_f32 v99, v99
    v_exp_f32 v100, v100
    v_exp_f32 v101, v101
    v_exp_f32 v102, v102
    v_smfmac_f32_32x32x32_bf16 v[120:135], v[48:51], v[88:95], v6
    v_exp_f32 v103, v103
    v_exp_f32 v104, v104
    v_exp_f32 v105, v105
    v_smfmac_f32_32x32x32_bf16 v[120:135], v[52:55], v[96:103], v6
    v_exp_f32 v106, v106
    v_exp_f32 v107, v107
    v_exp_f32 v108, v108
    v_mfma_f32_32x32x16_bf16 v[56:71], v[16:19], v[24:27], v[56:71]
    v_exp_f32 v109, v109
    v_exp_f32 v110, v110
    v_exp_f32 v111, v111
    v_mfma_f32_32x32x16_bf16 v[72:87], v[16:19], v[28:31], v[72:87]
    v_exp_f32 v112, v112
    v_exp_f32 v113, v113
    v_exp_f32 v114, v114
    v_smfmac_f32_32x32x32_bf16 v[136:151], v[48:51], v[104:111], v6
    v_exp_f32 v115, v115
    v_exp_f32 v116, v116
    v_exp_f32 v117, v117
    v_exp_f32 v118, v118
    v_exp_f32 v119, v119
    v_exp_f32 v56, v56
    v_exp_f32 v57, v57
    v_smfmac_f32_32x32x32_bf16 v[136:151], v[52:55], v[112:119], v6
    v_exp_f32 v58, v58
    v_exp_f32 v59, v59
    v_exp_f32 v60, v60
    v_mfma_f32_32x32x4_2b_bf16 v[88:119], v[8:9], v[10:11], 0 cbsz:1 abid:1
    v_exp_f32 v61, v61
    v_exp_f32 v62, v62
    v_exp_f32 v63, v63
    v_exp_f32 v64, v64
    v_exp_f32 v65, v65
    v_exp_f32 v66, v66
    v_exp_f32 v67, v67
    v_exp_f32 v68, v68
    v_exp_f32 v69, v69
    v_exp_f32 v70, v70
    v_smfmac_f32_32x32x32_bf16 v[120:135], v[40:43], v[56:63], v6
    v_exp_f32 v71, v71
    v_exp_f32 v72, v72
    v_exp_f32 v73, v73
    v_smfmac_f32_32x32x32_bf16 v[120:135], v[44:47], v[64:71], v6
    v_exp_f32 v74, v74
    v_exp_f32 v75, v75
    v_exp_f32 v76, v76
    v_mfma_f32_32x32x16_bf16 v[88:103], v[20:23], v[24:27], v[88:103]
    v_exp_f32 v77, v77
    v_exp_f32 v78, v78
    v_exp_f32 v79, v79
    v_mfma_f32_32x32x16_bf16 v[104:119], v[20:23], v[28:31], v[104:119]
    v_exp_f32 v80, v80
    v_exp_f32 v81, v81
    v_exp_f32 v82, v82
    v_smfmac_f32_32x32x32_bf16 v[136:151], v[40:43], v[72:79], v6
    v_exp_f32 v83, v83
    v_exp_f32 v84, v84
    v_exp_f32 v85, v85
    v_exp_f32 v86, v86
    v_exp_f32 v87, v87
    v_exp_f32 v88, v88
    v_exp_f32 v89, v89
    v_smfmac_f32_32x32x32_bf16 v[136:151], v[44:47], v[80:87], v6
    v_exp_f32 v90, v90
    v_exp_f32 v91, v91
    s_cbranch_vccz L_topB0
L_tail:
    v_exp_f32 v92, v92
    v_exp_f32 v93, v93
    v_exp_f32 v94, v94
    v_exp_f32 v95, v95
    v_exp_f32 v96, v96
    v_exp_f32 v97, v97
    v_smfmac_f32_32x32x32_bf16 v[120:135], v[168:171], v[88:95], v6
    v_exp_f32 v98, v98
    v_exp_f32 v99, v99
    v_exp_f32 v100, v100
    v_exp_f32 v101, v101
    v_exp_f32 v102, v102
    v_exp_f32 v103, v103
    v_exp_f32 v104, v104
    v_exp_f32 v105, v105
    v_smfmac_f32_32x32x32_bf16 v[120:135], v[172:175], v[96:103], v6
    s_nop 1
    v_exp_f32 v106, v106
    v_exp_f32 v107, v107
    v_exp_f32 v108, v108
    v_exp_f32 v109, v109
    v_exp_f32 v110, v110
    v_exp_f32 v111, v111
    v_exp_f32 v112, v112
    v_exp_f32 v113, v113
    v_exp_f32 v114, v114
    v_exp_f32 v115, v115
    v_pk_mov_b32 v[58:59], v[128:129], v[128:129] op_sel:[0,0]
    v_exp_f32 v116, v116
    v_exp_f32 v117, v117
    v_permlane32_swap_b32 v58, v59
    v_rcp_f32 v58, v59
    v_exp_f32_e64 v118, v118
    v_pk_mul_f32 v[128:129], v[128:129], v[58:59] op_sel_hi:[1,0]
    v_pk_mul_f32 v[120:121], v[120:121], v[58:59] op_sel_hi:[1,0]
    v_pk_mul_f32 v[122:123], v[122:123], v[58:59] op_sel_hi:[1,0]
    v_pk_mul_f32 v[124:125], v[124:125], v[58:59] op_sel_hi:[1,0]
    v_pk_mul_f32 v[126:127], v[126:127], v[58:59] op_sel_hi:[1,0]
    v_cvt_pk_bf16_f32 v68, v128, v129
    v_cvt_pk_bf16_f32 v64, v120, v121
    v_cvt_pk_bf16_f32 v65, v122, v123
    v_cvt_pk_bf16_f32 v66, v124, v125
    v_cvt_pk_bf16_f32 v67, v126, v127
    v_smfmac_f32_32x32x32_bf16 v[136:151], v[168:171], v[104:111], v6
    ds_write_b32 v181, v68 offset:16
    ds_write2_b32 v181, v64, v65 offset0:0 offset1:1
    v_exp_f32_e64 v119, v119
    ds_write2_b32 v181, v66, v67 offset0:2 offset1:3
    ds_read_b128 v[76:79], v183
    v_smfmac_f32_32x32x32_bf16 v[136:151], v[172:175], v[112:119], v6
    s_nop 9
    s_waitcnt lgkmcnt(0)
    buffer_store_dwordx4 v[76:79], v14, s[20:23], 0 offen offset:0 sc1
    v_pk_mov_b32 v[60:61], v[144:145], v[144:145] op_sel:[0,0]
    s_nop 1
    v_permlane32_swap_b32 v60, v61
    v_rcp_f32 v60, v61
    s_nop 0
    v_pk_mul_f32 v[144:145], v[144:145], v[60:61] op_sel_hi:[1,0]
    v_pk_mul_f32 v[136:137], v[136:137], v[60:61] op_sel_hi:[1,0]
    v_pk_mul_f32 v[138:139], v[138:139], v[60:61] op_sel_hi:[1,0]
    v_pk_mul_f32 v[140:141], v[140:141], v[60:61] op_sel_hi:[1,0]
    v_pk_mul_f32 v[142:143], v[142:143], v[60:61] op_sel_hi:[1,0]
    v_cvt_pk_bf16_f32 v74, v144, v145
    v_cvt_pk_bf16_f32 v70, v136, v137
    v_cvt_pk_bf16_f32 v71, v138, v139
    v_cvt_pk_bf16_f32 v72, v140, v141
    v_cvt_pk_bf16_f32 v73, v142, v143
    ds_write_b32 v182, v74 offset:16
    ds_write2_b32 v182, v70, v71 offset0:0 offset1:1
    ds_write2_b32 v182, v72, v73 offset0:2 offset1:3
    ds_read_b128 v[80:83], v183 offset:1024
    ds_read_b128 v[84:87], v183 offset:2048
    s_waitcnt lgkmcnt(1)
    buffer_store_dwordx4 v[80:83], v14, s[20:23], 0 offen offset:1024 sc1
    s_waitcnt lgkmcnt(0)
    buffer_store_dwordx4 v[84:87], v14, s[20:23], 0 offen offset:2048 sc1
    s_setprio 0
    v_dot2c_f32_bf16 v59, 0, v64
    v_dot2c_f32_bf16 v59, 0, v65
    v_dot2c_f32_bf16 v59, 0, v66
    v_dot2c_f32_bf16 v59, 0, v67
    v_dot2c_f32_bf16 v59, 0, v68
    v_dot2c_f32_bf16 v61, 0, v70
    v_dot2c_f32_bf16 v61, 0, v71
    v_dot2c_f32_bf16 v61, 0, v72
    v_dot2c_f32_bf16 v61, 0, v73
    v_dot2c_f32_bf16 v61, 0, v74
    v_cmp_nge_f32 s[36:37], v59, 1.0
    v_cmp_nle_f32 vcc, v59, s35
    s_or_b64 s[36:37], s[36:37], vcc
    v_cmp_nge_f32 s[38:39], v61, 1.0
    v_cmp_nle_f32 vcc, v61, s35
    s_or_b64 s[36:37], s[36:37], s[38:39]
    s_or_b64 s[36:37], s[36:37], vcc
    s_cbranch_scc1 L_slow
L_done:
L_end:
    s_endpgm
L_slow:
    s_waitcnt vmcnt(0)
    s_mov_b32 s29, 0
    v_mov_b32 v0, 0xff800000
    v_mov_b32 v1, 0xff800000
L_max:
    buffer_load_dword v8, v185, s[16:19], s29 offen offset:32
    buffer_load_dwordx4 v[16:19], v184, s[16:19], s29 offen
    buffer_load_dwordx4 v[20:23], v184, s[16:19], s29 offen offset:36
    s_waitcnt vmcnt(0) lgkmcnt(0)
    v_mfma_f32_32x32x4_2b_bf16 v[56:87], v[8:9], v[10:11], 0 cbsz:1 abid:0
    v_mfma_f32_32x32x4_2b_bf16 v[88:119], v[8:9], v[10:11], 0 cbsz:1 abid:1
    s_nop 15
    s_nop 3
    v_mfma_f32_32x32x16_bf16 v[56:71], v[16:19], v[24:27], v[56:71]
    v_mfma_f32_32x32x16_bf16 v[72:87], v[16:19], v[28:31], v[72:87]
    v_mfma_f32_32x32x16_bf16 v[88:103], v[20:23], v[24:27], v[88:103]
    v_mfma_f32_32x32x16_bf16 v[104:119], v[20:23], v[28:31], v[104:119]
    s_nop 15
    v_max3_f32 v0, v0, v56, v57
    v_max3_f32 v0, v0, v58, v59
    v_max3_f32 v0, v0, v60, v61
    v_max3_f32 v0, v0, v62, v63
    v_max3_f32 v0, v0, v64, v65
    v_max3_f32 v0, v0, v66, v67
    v_max3_f32 v0, v0, v68, v69
    v_max3_f32 v0, v0, v70, v71
    v_max3_f32 v1, v1, v72, v73
    v_max3_f32 v1, v1, v74, v75
    v_max3_f32 v1, v1, v76, v77
    v_max3_f32 v1, v1, v78, v79
    v_max3_f32 v1, v1, v80, v81
    v_max3_f32 v1, v1, v82, v83
    v_max3_f32 v1, v1, v84, v85
    v_max3_f32 v1, v1, v86, v87
    v_max3_f32 v0, v0, v88, v89
    v_max3_f32 v0, v0, v90, v91
    v_max3_f32 v0, v0, v92, v93
    v_max3_f32 v0, v0, v94, v95
    v_max3_f32 v0, v0, v96, v97
    v_max3_f32 v0, v0, v98, v99
    v_max3_f32 v0, v0, v100, v101
    v_max3_f32 v0, v0, v102, v103
    v_max3_f32 v1, v1, v104, v105
    v_max3_f32 v1, v1, v106, v107
    v_max3_f32 v1, v1, v108, v109
    v_max3_f32 v1, v1, v110, v111
    v_max3_f32 v1, v1, v112, v113
    v_max3_f32 v1, v1, v114, v115
    v_max3_f32 v1, v1, v116, v117
    v_max3_f32 v1, v1, v118, v119
    s_add_u32 s29, s29, 2304
    s_cmp_lg_u32 s29, s18
    s_cbranch_scc1 L_max
    v_mov_b32 v15, v0
    s_nop 1
    v_permlane32_swap_b32 v15, v0
    s_nop 1
    v_max_f32 v0, v0, v15
    v_mov_b32 v15, v1
    s_nop 1
    v_permlane32_swap_b32 v15, v1
    s_nop 1
    v_max_f32 v1, v1, v15
    v_subrev_u32 v3, 64512, v3
    s_mov_b32 s29, 0
    v_mov_b32 v120, 0
    v_mov_b32 v121, 0
    v_mov_b32 v122, 0
    v_mov_b32 v123, 0
    v_mov_b32 v124, 0
    v_mov_b32 v125, 0
    v_mov_b32 v126, 0
    v_mov_b32 v127, 0
    v_mov_b32 v128, 0
    v_mov_b32 v129, 0
    v_mov_b32 v130, 0
    v_mov_b32 v131, 0
    v_mov_b32 v132, 0
    v_mov_b32 v133, 0
    v_mov_b32 v134, 0
    v_mov_b32 v135, 0
    v_mov_b32 v136, 0
    v_mov_b32 v137, 0
    v_mov_b32 v138, 0
    v_mov_b32 v139, 0
    v_mov_b32 v140, 0
    v_mov_b32 v141, 0
    v_mov_b32 v142, 0
    v_mov_b32 v143, 0
    v_mov_b32 v144, 0
    v_mov_b32 v145, 0
    v_mov_b32 v146, 0
    v_mov_b32 v147, 0
    v_mov_b32 v148, 0
    v_mov_b32 v149, 0
    v_mov_b32 v150, 0
    v_mov_b32 v151, 0
L_acc:
    s_mov_b64 exec, s[12:13]
    ds_read_b128 v[40:43], v3 offset:0
    ds_read_b128 v[44:47], v3 offset:576
    ds_read_b128 v[48:51], v3 offset:1152
    ds_read_b128 v[52:55], v3 offset:1728
    s_mov_b64 exec, -1
    buffer_load_dword v8, v185, s[16:19], s29 offen offset:32
    buffer_load_dwordx4 v[16:19], v184, s[16:19], s29 offen
    buffer_load_dwordx4 v[20:23], v184, s[16:19], s29 offen offset:36
    s_waitcnt vmcnt(0) lgkmcnt(0)
    v_mfma_f32_32x32x4_2b_bf16 v[56:87], v[8:9], v[10:11], 0 cbsz:1 abid:0
    v_mfma_f32_32x32x4_2b_bf16 v[88:119], v[8:9], v[10:11], 0 cbsz:1 abid:1
    s_nop 15
    s_nop 3
    v_mfma_f32_32x32x16_bf16 v[56:71], v[16:19], v[24:27], v[56:71]
    v_mfma_f32_32x32x16_bf16 v[72:87], v[16:19], v[28:31], v[72:87]
    v_mfma_f32_32x32x16_bf16 v[88:103], v[20:23], v[24:27], v[88:103]
    v_mfma_f32_32x32x16_bf16 v[104:119], v[20:23], v[28:31], v[104:119]
    s_nop 15
    v_sub_f32 v56, v56, v0
    v_sub_f32 v57, v57, v0
    v_sub_f32 v58, v58, v0
    v_sub_f32 v59, v59, v0
    v_sub_f32 v60, v60, v0
    v_sub_f32 v61, v61, v0
    v_sub_f32 v62, v62, v0
    v_sub_f32 v63, v63, v0
    v_sub_f32 v64, v64, v0
    v_sub_f32 v65, v65, v0
    v_sub_f32 v66, v66, v0
    v_sub_f32 v67, v67, v0
    v_sub_f32 v68, v68, v0
    v_sub_f32 v69, v69, v0
    v_sub_f32 v70, v70, v0
    v_sub_f32 v71, v71, v0
    v_exp_f32 v56, v56
    v_exp_f32 v57, v57
    v_exp_f32 v58, v58
    v_exp_f32 v59, v59
    v_exp_f32 v60, v60
    v_exp_f32 v61, v61
    v_exp_f32 v62, v62
    v_exp_f32 v63, v63
    v_exp_f32 v64, v64
    v_exp_f32 v65, v65
    v_exp_f32 v66, v66
    v_exp_f32 v67, v67
    v_exp_f32 v68, v68
    v_exp_f32 v69, v69
    v_exp_f32 v70, v70
    v_exp_f32 v71, v71
    v_sub_f32 v72, v72, v1
    v_sub_f32 v73, v73, v1
    v_sub_f32 v74, v74, v1
    v_sub_f32 v75, v75, v1
    v_sub_f32 v76, v76, v1
    v_sub_f32 v77, v77, v1
    v_sub_f32 v78, v78, v1
    v_sub_f32 v79, v79, v1
    v_sub_f32 v80, v80, v1
    v_sub_f32 v81, v81, v1
    v_sub_f32 v82, v82, v1
    v_sub_f32 v83, v83, v1
    v_sub_f32 v84, v84, v1
    v_sub_f32 v85, v85, v1
    v_sub_f32 v86, v86, v1
    v_sub_f32 v87, v87, v1
    v_exp_f32 v72, v72
    v_exp_f32 v73, v73
    v_exp_f32 v74, v74
    v_exp_f32 v75, v75
    v_exp_f32 v76, v76
    v_exp_f32 v77, v77
    v_exp_f32 v78, v78
    v_exp_f32 v79, v79
    v_exp_f32 v80, v80
    v_exp_f32 v81, v81
    v_exp_f32 v82, v82
    v_exp_f32 v83, v83
    v_exp_f32 v84, v84
    v_exp_f32 v85, v85
    v_exp_f32 v86, v86
    v_exp_f32 v87, v87
    v_sub_f32 v88, v88, v0
    v_sub_f32 v89, v89, v0
    v_sub_f32 v90, v90, v0
    v_sub_f32 v91, v91, v0
    v_sub_f32 v92, v92, v0
    v_sub_f32 v93, v93, v0
    v_sub_f32 v94, v94, v0
    v_sub_f32 v95, v95, v0
    v_sub_f32 v96, v96, v0
    v_sub_f32 v97, v97, v0
    v_sub_f32 v98, v98, v0
    v_sub_f32 v99, v99, v0
    v_sub_f32 v100, v100, v0
    v_sub_f32 v101, v101, v0
    v_sub_f32 v102, v102, v0
    v_sub_f32 v103, v103, v0
    v_exp_f32 v88, v88
    v_exp_f32 v89, v89
    v_exp_f32 v90, v90
    v_exp_f32 v91, v91
    v_exp_f32 v92, v92
    v_exp_f32 v93, v93
    v_exp_f32 v94, v94
    v_exp_f32 v95, v95
    v_exp_f32 v96, v96
    v_exp_f32 v97, v97
    v_exp_f32 v98, v98
    v_exp_f32 v99, v99
    v_exp_f32 v100, v100
    v_exp_f32 v101, v101
    v_exp_f32 v102, v102
    v_exp_f32 v103, v103
    v_sub_f32 v104, v104, v1
    v_sub_f32 v105, v105, v1
    v_sub_f32 v106, v106, v1
    v_sub_f32 v107, v107, v1
    v_sub_f32 v108, v108, v1
    v_sub_f32 v109, v109, v1
    v_sub_f32 v110, v110, v1
    v_sub_f32 v111, v111, v1
    v_sub_f32 v112, v112, v1
    v_sub_f32 v113, v113, v1
    v_sub_f32 v114, v114, v1
    v_sub_f32 v115, v115, v1
    v_sub_f32 v116, v116, v1
    v_sub_f32 v117, v117, v1
    v_sub_f32 v118, v118, v1
    v_sub_f32 v119, v119, v1
    v_exp_f32 v104, v104
    v_exp_f32 v105, v105
    v_exp_f32 v106, v106
    v_exp_f32 v107, v107
    v_exp_f32 v108, v108
    v_exp_f32 v109, v109
    v_exp_f32 v110, v110
    v_exp_f32 v111, v111
    v_exp_f32 v112, v112
    v_exp_f32 v113, v113
    v_exp_f32 v114, v114
    v_exp_f32 v115, v115
    v_exp_f32 v116, v116
    v_exp_f32 v117, v117
    v_exp_f32 v118, v118
    v_exp_f32 v119, v119
    v_add_u32 v3, 2304, v3
    s_nop 0
    v_smfmac_f32_32x32x32_bf16 v[120:135], v[40:43], v[56:63], v6
    v_smfmac_f32_32x32x32_bf16 v[120:135], v[44:47], v[64:71], v6
    v_smfmac_f32_32x32x32_bf16 v[136:151], v[40:43], v[72:79], v6
    v_smfmac_f32_32x32x32_bf16 v[136:151], v[44:47], v[80:87], v6
    v_smfmac_f32_32x32x32_bf16 v[120:135], v[48:51], v[88:95], v6
    v_smfmac_f32_32x32x32_bf16 v[120:135], v[52:55], v[96:103], v6
    v_smfmac_f32_32x32x32_bf16 v[136:151], v[48:51], v[104:111], v6
    v_smfmac_f32_32x32x32_bf16 v[136:151], v[52:55], v[112:119], v6
    s_add_u32 s29, s29, 2304
    s_cmp_lg_u32 s29, s18
    s_cbranch_scc1 L_acc
    s_nop 15
    v_pk_mov_b32 v[58:59], v[128:129], v[128:129] op_sel:[0,0]
    s_nop 1
    v_permlane32_swap_b32 v58, v59
    v_rcp_f32 v58, v59
    s_nop 0
    v_pk_mul_f32 v[128:129], v[128:129], v[58:59] op_sel_hi:[1,0]
    v_pk_mul_f32 v[120:121], v[120:121], v[58:59] op_sel_hi:[1,0]
    v_pk_mul_f32 v[122:123], v[122:123], v[58:59] op_sel_hi:[1,0]
    v_pk_mul_f32 v[124:125], v[124:125], v[58:59] op_sel_hi:[1,0]
    v_pk_mul_f32 v[126:127], v[126:127], v[58:59] op_sel_hi:[1,0]
    v_cvt_pk_bf16_f32 v68, v128, v129
    v_cvt_pk_bf16_f32 v64, v120, v121
    v_cvt_pk_bf16_f32 v65, v122, v123
    v_cvt_pk_bf16_f32 v66, v124, v125
    v_cvt_pk_bf16_f32 v67, v126, v127
    ds_write_b32 v181, v68 offset:16
    ds_write2_b32 v181, v64, v65 offset0:0 offset1:1
    ds_write2_b32 v181, v66, v67 offset0:2 offset1:3
    ds_read_b128 v[76:79], v183
    v_pk_mov_b32 v[60:61], v[144:145], v[144:145] op_sel:[0,0]
    s_nop 1
    v_permlane32_swap_b32 v60, v61
    v_rcp_f32 v60, v61
    s_nop 0
    v_pk_mul_f32 v[144:145], v[144:145], v[60:61] op_sel_hi:[1,0]
    v_pk_mul_f32 v[136:137], v[136:137], v[60:61] op_sel_hi:[1,0]
    v_pk_mul_f32 v[138:139], v[138:139], v[60:61] op_sel_hi:[1,0]
    v_pk_mul_f32 v[140:141], v[140:141], v[60:61] op_sel_hi:[1,0]
    v_pk_mul_f32 v[142:143], v[142:143], v[60:61] op_sel_hi:[1,0]
    v_cvt_pk_bf16_f32 v74, v144, v145
    v_cvt_pk_bf16_f32 v70, v136, v137
    v_cvt_pk_bf16_f32 v71, v138, v139
    v_cvt_pk_bf16_f32 v72, v140, v141
    v_cvt_pk_bf16_f32 v73, v142, v143
    ds_write_b32 v182, v74 offset:16
    ds_write2_b32 v182, v70, v71 offset0:0 offset1:1
    ds_write2_b32 v182, v72, v73 offset0:2 offset1:3
    ds_read_b128 v[80:83], v183 offset:1024
    ds_read_b128 v[84:87], v183 offset:2048
    s_waitcnt lgkmcnt(0)
    buffer_store_dwordx4 v[76:79], v14, s[20:23], 0 offen offset:0 sc1
    buffer_store_dwordx4 v[80:83], v14, s[20:23], 0 offen offset:1024 sc1
    buffer_store_dwordx4 v[84:87], v14, s[20:23], 0 offen offset:2048 sc1
    s_branch L_done
.section .rodata,"a"
.p2align 6
.amdhsa_kernel standalone__fused_io_aware_attn__prompt_kernel
  .amdhsa_next_free_vgpr 188
  .amdhsa_next_free_sgpr 48
  .amdhsa_accum_offset 188
  .amdhsa_group_segment_fixed_size 0
  .amdhsa_kernarg_size 48
  .amdhsa_user_sgpr_count 2
  .amdhsa_user_sgpr_kernarg_segment_ptr 1
  .amdhsa_system_sgpr_workgroup_id_x 1
.end_amdhsa_kernel
```
